```python
import torch

def _softmax(x, axis=-1):
    return torch.softmax(x, dim=axis)
def _gelu(x):
    return torch.nn.functional.gelu(x, approximate="tanh")
def _silu(x):
    return torch.nn.functional.silu(x)
def _sigmoid(x):
    return torch.sigmoid(x)
def _layernorm(x, axis=-1, eps=1e-5):
    m = x.mean(dim=axis, keepdim=True)
    v = x.var(dim=axis, keepdim=True, unbiased=False)
    return (x - m) / torch.sqrt(v + eps)
def _scatter_add(tgt, idx, src, axis=0):
    return tgt.clone().index_add_(axis, idx, src)
def _segment_sum(src, seg, n):
    out = torch.zeros((n,) + src.shape[1:], dtype=src.dtype)
    return out.index_add_(0, seg, src)
def _pad(x, pw):
    flat = tuple(v for pair in reversed(pw) for v in pair)
    return torch.nn.functional.pad(x, flat)

kernel_name = 'recurrent_scan__sliding_block_cached__mixer_token_mlp__decode'

def setup_inputs():

    _w = (lambda a: (lambda t: t.to(torch.bfloat16) if t.is_floating_point() else t)(torch.as_tensor(a)))
    def _A_setup():
        B, Sq, D = 4, 1, 512
        Hq, Hkv, Sk, Dh = 32, 8, 4096, 128
        assert Hq % Hkv == 0, (Hq, Hkv)
        return {
            "x": _w((lambda *s: torch.randn(*s, dtype=torch.bfloat16) * 0.05)(B, Sq, D)),
            "k_cache": _w((lambda *s: torch.randn(*s, dtype=torch.bfloat16) * 3.2)(B, Hkv, Sk, Dh)),
            "v_cache": _w((lambda *s: torch.randn(*s, dtype=torch.bfloat16) * 3.2)(B, Hkv, Sk, Dh)),
            "wq": _w((lambda *s: torch.randn(*s, dtype=torch.bfloat16) * 3.2)(D, Hq * Dh) * (D ** -0.5)),
            "wo": _w((lambda *s: torch.randn(*s, dtype=torch.bfloat16) * 3.2)(Hq * Dh, D) * ((Hq * Dh) ** -0.5)),
        }
    _A_in = _A_setup()

    def _B_setup():
        B, S, D, F = 4, 1, 512, 1792
        return {
            "x": _w((lambda *s: torch.randn(*s, dtype=torch.bfloat16) * 0.05)(B, S, D)),
            "w1": _w((lambda *s: torch.randn(*s, dtype=torch.bfloat16) * 3.2)(S, F) * (S ** -0.5)),
            "b1": _w((lambda *s: torch.randn(*s, dtype=torch.bfloat16) * 3.2)(F) * 0.02),
            "w2": _w((lambda *s: torch.randn(*s, dtype=torch.bfloat16) * 0.4)(F, S) * (F ** -0.5)),
            "b2": _w((lambda *s: torch.randn(*s, dtype=torch.bfloat16) * 0.4)(S) * 0.02),
        }
    _B_in = _B_setup()

    return {
        "A_x": _A_in["x"],
        "A_k_cache": _A_in["k_cache"],
        "A_v_cache": _A_in["v_cache"],
        "A_wq": _A_in["wq"],
        "A_wo": _A_in["wo"],
        "B_x": _B_in["x"],
        "B_w1": _B_in["w1"],
        "B_b1": _B_in["b1"],
        "B_w2": _B_in["w2"],
        "B_b2": _B_in["b2"],
    }

def reference(A_x, A_k_cache, A_v_cache, A_wq, A_wo, B_x, B_w1, B_b1, B_w2, B_b2):
    def _A_ref(x, k_cache, v_cache, wq, wo):
        B, Sq, D = x.shape
        Hq, Dh = 32, 128
        Hkv, Sk = k_cache.shape[1], k_cache.shape[2]
        W = min(4096, max(256, Sk // 4))
        rep = Hq // Hkv
        q = (lambda x, *d: x.permute(*d))((x @ wq).reshape(B, Sq, Hq, Dh), 0, 2, 1, 3)
        k = (lambda x, n, axis: torch.repeat_interleave(x, n, dim=axis))(k_cache[:, :, Sk - W:, :], rep, axis=1)
        v = (lambda x, n, axis: torch.repeat_interleave(x, n, dim=axis))(v_cache[:, :, Sk - W:, :], rep, axis=1)
        scores = torch.einsum("bhqd,bhkd->bhqk", q, k) * (Dh ** -0.5)
        p = _softmax(scores, axis=-1)
        o = torch.einsum("bhqk,bhkd->bhqd", p, v)
        return (lambda x, *d: x.permute(*d))(o, 0, 2, 1, 3).reshape(B, Sq, Hq * Dh) @ wo

    def _B_ref(x, w1, b1, w2, b2):
        B, S, D = x.shape
        h = _layernorm(x, axis=-1)
        u = torch.einsum("bsd,sf->bdf", h, w1) + b1
        u = _gelu(u)
        y = torch.einsum("bdf,fs->bds", u, w2) + b2
        return (lambda x, *d: x.permute(*d))(y, 0, 2, 1)

    x = A_x
    xn = _layernorm(x, axis=-1)
    s = _A_ref(xn, A_k_cache, A_v_cache, A_wq, A_wo)
    g = _silu(_B_ref(xn, B_w1, B_b1, B_w2, B_b2))
    return x + s * g
```

```asm
; @launch grid=(256,1,1) block=(768,1,1) lds=44160
.amdgcn_target "amdgcn-amd-amdhsa--gfx950"
.text
.globl recurrent_scan__sliding_block_cached__mixer_token_mlp__decode_kernel
.p2align 8
.type recurrent_scan__sliding_block_cached__mixer_token_mlp__decode_kernel,@function
recurrent_scan__sliding_block_cached__mixer_token_mlp__decode_kernel:
    s_cmp_ge_u32 s2, 256
    s_cbranch_scc1 L_end
    s_load_dwordx16 s[4:19], s[0:1], 0
    s_load_dwordx8 s[20:27], s[0:1], 64
    s_load_dwordx2 s[28:29], s[0:1], 96
    v_lshrrev_b32 v1, 6, v0
    v_and_b32 v2, 0xff, v0
    v_and_b32 v0, 63, v0
    v_readfirstlane_b32 s36, v1
    s_and_b32 s32, s2, 7
    s_lshr_b32 s33, s2, 3
    s_lshr_b32 s34, s2, 6
    s_and_b32 s35, s33, 7
    v_lshlrev_b32 v2, 4, v2
    v_and_b32 v1, 15, v0
    v_lshrrev_b32 v6, 4, v0
    s_mov_b32 s40, 0x05040100
    s_mov_b32 s41, 0x07060302
    s_and_b32 s37, s36, 3
    s_lshl_b32 s47, s32, 5
    s_add_u32 s47, s47, s33
    s_lshl_b32 s47, s47, 4
    s_cmp_lt_u32 s36, 4
    s_cbranch_scc1 L_B
    s_cmp_ge_u32 s36, 8
    s_cbranch_scc1 L_C0
    s_lshl_b32 s44, s34, 3
    s_add_u32 s44, s44, s32
    s_lshl_b32 s44, s44, 20
    s_lshl_b32 s45, s35, 14
    s_add_u32 s44, s44, s45
    s_lshl_b32 s45, s37, 12
    s_add_u32 s44, s44, s45
    s_add_u32 s44, s44, 786432
    v_lshlrev_b32 v3, 8, v1
    v_lshl_add_u32 v3, v6, 4, v3

    s_add_u32 s45, s44, 131072
    s_lshr_b32 s46, s33, 2
    s_lshl_b32 s38, s32, 19
    s_and_b32 s39, s46, 1
    s_lshl_b32 s39, s39, 18
    s_add_u32 s38, s38, s39
    s_and_b32 s39, s37, 1
    s_lshl_b32 s39, s39, 17
    s_add_u32 s38, s38, s39
    s_lshr_b32 s39, s46, 1
    s_lshl_b32 s39, s39, 15
    s_add_u32 s38, s38, s39
    s_lshr_b32 s39, s37, 1
    s_lshl_b32 s39, s39, 12
    s_add_u32 s38, s38, s39
    s_and_b32 s39, s33, 3
    s_lshl_b32 s39, s39, 8
    s_add_u32 s38, s38, s39
    v_lshlrev_b32 v4, 4, v1
    v_lshl_add_u32 v4, v6, 10, v4
    v_add_u32 v5, s38, v4

    s_waitcnt lgkmcnt(0)
    s_load_dword s30, s[28:29], 0
    s_add_u32 s70, s6, s45
    s_addc_u32 s71, s7, 0
    s_add_u32 s6, s6, s44
    s_addc_u32 s7, s7, 0
    s_add_u32 s72, s8, s45
    s_addc_u32 s73, s9, 0
    s_add_u32 s8, s8, s44
    s_addc_u32 s9, s9, 0
    s_barrier
    global_load_dwordx4 v[16:19], v3, s[6:7] offset:0 nt
    global_load_dwordx4 v[20:23], v3, s[6:7] offset:64 nt
    global_load_dwordx4 v[24:27], v3, s[6:7] offset:128 nt
    global_load_dwordx4 v[28:31], v3, s[6:7] offset:192 nt
    s_branch L_A
L_C0:

    v_mov_b32 v12, 44032
    v_mov_b32 v14, 0
    v_mov_b32 v15, 0
    ds_write_b64 v12, v[14:15]
    ds_write_b64 v12, v[14:15] offset:8
    v_cmp_gt_u32 vcc, 0xE00, v2
    v_mov_b32 v80, 0
    v_mov_b32 v81, 0
    v_mov_b32 v82, 0
    v_mov_b32 v83, 0
    v_mov_b32 v84, 0
    v_mov_b32 v85, 0
    v_mov_b32 v86, 0
    v_mov_b32 v87, 0
    v_mov_b32 v88, 0
    v_mov_b32 v89, 0
    v_mov_b32 v90, 0
    v_mov_b32 v91, 0
    v_mov_b32 v92, 0
    v_mov_b32 v93, 0
    v_mov_b32 v94, 0
    v_mov_b32 v95, 0
    s_lshl_b32 s54, s32, 5
    s_add_u32 s54, s54, s33
    s_lshl_b32 s54, s54, 11
    s_add_u32 s54, s54, 524544
    s_and_b32 s56, s33, 3
    s_lshl_b32 s56, s56, 3
    s_add_u32 s56, s56, s32
    s_lshl_b32 s56, s56, 3
    s_lshr_b32 s39, s33, 2
    s_add_u32 s56, s56, s39
    s_lshl_b32 s56, s56, 11
    s_add_u32 s56, s56, 1048832
    s_mov_b64 exec, vcc
    s_waitcnt lgkmcnt(0)

    global_load_dwordx4 v[80:83], v2, s[16:17]
    global_load_dwordx4 v[84:87], v2, s[18:19]
    global_load_dwordx4 v[88:91], v2, s[20:21]
    s_mov_b64 exec, -1
    s_add_u32 s54, s28, s54
    s_addc_u32 s55, s29, 0
    s_add_u32 s56, s28, s56
    s_addc_u32 s57, s29, 0
    s_barrier
    s_cmp_ge_u32 s36, 10
    s_cbranch_scc1 L_nowarm
    global_store_dwordx4 v2, v[92:95], s[54:55]
    global_store_dwordx4 v2, v[92:95], s[56:57] sc1
L_nowarm:
    s_branch L_C
L_B:
    s_setprio 3
    v_lshrrev_b32 v7, 3, v1
    v_lshlrev_b32 v7, 4, v7
    v_lshl_add_u32 v7, v6, 2, v7
    v_and_b32 v8, 7, v1
    v_lshlrev_b32 v8, 4, v8
    v_lshl_add_u32 v4, v7, 13, v8
    s_lshl_b32 s38, s34, 20
    s_lshl_b32 s39, s32, 10
    s_add_u32 s38, s38, s39
    s_lshl_b32 s39, s35, 7
    s_add_u32 s38, s38, s39
    s_lshl_b32 s39, s36, 18
    s_add_u32 s38, s38, s39
    v_add_u32 v4, s38, v4
    s_waitcnt lgkmcnt(0)
    global_load_dwordx4 v[16:19], v2, s[4:5]
    s_load_dword s30, s[28:29], 0
    s_load_dword s31, s[22:23], 0
    global_load_dwordx4 v[64:67], v4, s[10:11] nt
    v_add_u32 v4, 0x2000, v4
    global_load_dwordx4 v[68:71], v4, s[10:11] nt
    v_add_u32 v4, 0x2000, v4
    global_load_dwordx4 v[72:75], v4, s[10:11] nt
    v_add_u32 v4, 0x2000, v4
    global_load_dwordx4 v[76:79], v4, s[10:11] nt
    s_barrier
    v_mov_b32 v12, 44032
    s_mov_b32 s44, 0x3b000000
    s_mov_b32 s45, 0x3727c5ac
    s_mov_b32 s42, 0x0c0c0400
    s_mov_b32 s43, 0x04000c0c
    s_mul_i32 s38, s36, 1088
    v_lshlrev_b32 v7, 4, v0
    v_add_u32 v7, s38, v7
    v_and_b32 v9, 3, v1
    v_mul_u32_u24 v10, 1088, v9
    v_bfe_u32 v11, v1, 2, 1
    v_lshl_add_u32 v10, v11, 5, v10
    v_lshl_add_u32 v10, v6, 3, v10
    s_lshl_b32 s38, s34, 8
    s_lshl_b32 s39, s36, 6
    s_add_u32 s38, s38, s39
    v_add_u32 v10, s38, v10
    v_mul_u32_u24 v11, 20, v6
    v_add_lshl_u32 v11, v11, v1, 4
    s_mul_i32 s38, s36, 5184
    v_add_u32 v11, s38, v11
    v_mov_b32 v50, 0
    v_mov_b32 v51, 0
    v_mov_b32 v52, 0
    v_mov_b32 v53, 0
    s_lshl_b32 s38, s32, 15
    s_lshl_b32 s39, s33, 8
    s_add_u32 s38, s38, s39
    s_add_u32 s38, s38, 256
    s_add_u32 s50, s28, s38
    s_addc_u32 s51, s29, 0
    v_lshlrev_b32 v54, 4, v1
    v_lshl_add_u32 v54, v6, 13, v54
    s_waitcnt vmcnt(4)
    v_lshlrev_b32 v32, 16, v16
    v_and_b32 v33, 0xffff0000, v16
    v_lshlrev_b32 v34, 16, v17
    v_and_b32 v35, 0xffff0000, v17
    v_lshlrev_b32 v36, 16, v18
    v_and_b32 v37, 0xffff0000, v18
    v_lshlrev_b32 v38, 16, v19
    v_and_b32 v39, 0xffff0000, v19
    v_pk_add_f32 v[40:41], v[32:33], v[34:35]
    v_pk_add_f32 v[42:43], v[36:37], v[38:39]
    v_pk_add_f32 v[40:41], v[40:41], v[42:43]
    v_add_f32 v40, v40, v41
    s_nop 1
    v_add_f32_dpp v40, v40, v40 row_ror:8 row_mask:0xf bank_mask:0xf
    s_nop 1
    v_add_f32_dpp v40, v40, v40 row_ror:4 row_mask:0xf bank_mask:0xf
    s_nop 1
    v_add_f32_dpp v40, v40, v40 row_ror:2 row_mask:0xf bank_mask:0xf
    s_nop 1
    v_add_f32_dpp v40, v40, v40 row_ror:1 row_mask:0xf bank_mask:0xf
    v_mov_b32 v41, v40
    s_nop 1
    v_permlane16_swap_b32 v40, v41
    s_nop 0
    v_add_f32 v40, v40, v41
    v_mov_b32 v41, v40
    s_nop 1
    v_permlane32_swap_b32 v40, v41
    s_nop 0
    v_add_f32 v40, v40, v41
    v_mul_f32 v40, s44, v40
    v_pk_add_f32 v[42:43], v[32:33], v[40:41] op_sel_hi:[1,0] neg_lo:[0,1] neg_hi:[0,1]
    v_pk_add_f32 v[44:45], v[34:35], v[40:41] op_sel_hi:[1,0] neg_lo:[0,1] neg_hi:[0,1]
    v_pk_add_f32 v[46:47], v[36:37], v[40:41] op_sel_hi:[1,0] neg_lo:[0,1] neg_hi:[0,1]
    v_pk_add_f32 v[48:49], v[38:39], v[40:41] op_sel_hi:[1,0] neg_lo:[0,1] neg_hi:[0,1]
    v_pk_mul_f32 v[42:43], v[42:43], v[42:43]
    v_pk_fma_f32 v[42:43], v[44:45], v[44:45], v[42:43]
    v_pk_fma_f32 v[42:43], v[46:47], v[46:47], v[42:43]
    v_pk_fma_f32 v[42:43], v[48:49], v[48:49], v[42:43]
    v_add_f32 v42, v42, v43
    v_cvt_pk_bf16_f32 v40, 0, v40
    s_nop 0
    v_add_f32_dpp v42, v42, v42 row_ror:8 row_mask:0xf bank_mask:0xf
    v_pk_add_f32 v[32:33], v[32:33], v[40:41] op_sel_hi:[1,0] neg_lo:[0,1] neg_hi:[0,1]
    v_pk_add_f32 v[34:35], v[34:35], v[40:41] op_sel_hi:[1,0] neg_lo:[0,1] neg_hi:[0,1]
    v_add_f32_dpp v42, v42, v42 row_ror:4 row_mask:0xf bank_mask:0xf
    v_pk_add_f32 v[36:37], v[36:37], v[40:41] op_sel_hi:[1,0] neg_lo:[0,1] neg_hi:[0,1]
    v_pk_add_f32 v[38:39], v[38:39], v[40:41] op_sel_hi:[1,0] neg_lo:[0,1] neg_hi:[0,1]
    v_add_f32_dpp v42, v42, v42 row_ror:2 row_mask:0xf bank_mask:0xf
    v_cvt_pk_bf16_f32 v32, 0, v32
    v_cvt_pk_bf16_f32 v33, 0, v33
    v_add_f32_dpp v42, v42, v42 row_ror:1 row_mask:0xf bank_mask:0xf
    v_mov_b32 v43, v42
    v_cvt_pk_bf16_f32 v34, 0, v34
    v_cvt_pk_bf16_f32 v35, 0, v35
    v_permlane16_swap_b32 v42, v43
    v_cvt_pk_bf16_f32 v36, 0, v36
    v_add_f32 v42, v42, v43
    v_mov_b32 v43, v42
    v_cvt_pk_bf16_f32 v37, 0, v37
    v_cvt_pk_bf16_f32 v38, 0, v38
    v_permlane32_swap_b32 v42, v43
    v_cvt_pk_bf16_f32 v39, 0, v39
    v_add_f32 v42, v42, v43
    v_mul_f32 v42, s44, v42
    v_cvt_pk_bf16_f32 v42, 0, v42
    v_add_f32 v42, s45, v42
    v_cvt_pk_bf16_f32 v42, 0, v42
    v_sqrt_f32 v42, v42
    s_nop 0
    v_cvt_pk_bf16_f32 v42, 0, v42
    v_rcp_f32 v42, v42
    s_nop 0
    v_pk_mul_f32 v[32:33], v[32:33], v[42:43] op_sel_hi:[1,0]
    v_pk_mul_f32 v[34:35], v[34:35], v[42:43] op_sel_hi:[1,0]
    v_pk_mul_f32 v[36:37], v[36:37], v[42:43] op_sel_hi:[1,0]
    v_pk_mul_f32 v[38:39], v[38:39], v[42:43] op_sel_hi:[1,0]
    v_cvt_pk_bf16_f32 v16, v32, v33
    v_cvt_pk_bf16_f32 v17, v34, v35
    v_cvt_pk_bf16_f32 v18, v36, v37
    v_cvt_pk_bf16_f32 v19, v38, v39
    ds_write_b128 v7, v[16:19] offset:0
    v_mov_b32 v13, 1
    s_mov_b64 exec, 1
    s_waitcnt lgkmcnt(0)
    ds_add_u32 v12, v13 offset:4
    s_mov_b64 exec, -1
    s_mul_i32 s30, s30, 0x9E3779B1
    s_add_u32 s30, s30, 0x7F4A7C15
    s_or_b32 s30, s30, 1
    s_mov_b32 s39, 200000
L_spinB:

    ds_read_b32 v13, v12 offset:4
    s_sub_u32 s39, s39, 1
    s_cbranch_scc1 L_spindB
    s_waitcnt lgkmcnt(0)
    v_readfirstlane_b32 s38, v13
    s_cmp_lt_u32 s38, 4
    s_cbranch_scc1 L_spinB
L_spindB:
    s_mov_b32 exec_lo, 0x00ff00ff
    s_mov_b32 exec_hi, 0x00ff00ff
    ds_read_b64 v[50:51], v10 offset:0
    s_not_b64 exec, exec
    ds_read_b64 v[52:53], v10 offset:0
    s_mov_b64 exec, -1
    s_waitcnt vmcnt(0)
    v_perm_b32 v80, v68, v64, s40
    v_perm_b32 v81, v76, v72, s40
    v_perm_b32 v82, v68, v64, s41
    v_perm_b32 v83, v76, v72, s41
    v_perm_b32 v84, v69, v65, s40
    v_perm_b32 v85, v77, v73, s40
    v_perm_b32 v86, v69, v65, s41
    v_perm_b32 v87, v77, v73, s41
    v_perm_b32 v88, v70, v66, s40
    v_perm_b32 v89, v78, v74, s40
    v_perm_b32 v90, v70, v66, s41
    v_perm_b32 v91, v78, v74, s41
    v_perm_b32 v92, v71, v67, s40
    v_perm_b32 v93, v79, v75, s40
    v_perm_b32 v94, v71, v67, s41
    v_perm_b32 v95, v79, v75, s41
    s_waitcnt lgkmcnt(0)
    v_mfma_f32_16x16x32_bf16 v[96:99], v[80:83], v[50:53], 0
    v_mfma_f32_16x16x32_bf16 v[100:103], v[84:87], v[50:53], 0
    v_mfma_f32_16x16x32_bf16 v[104:107], v[88:91], v[50:53], 0
    v_mfma_f32_16x16x32_bf16 v[108:111], v[92:95], v[50:53], 0
    v_bfe_u32 v14, v1, 1, 2
    v_mul_u32_u24 v14, 81, v14
    v_lshrrev_b32 v15, 3, v1
    v_mul_u32_u24 v15, 20, v15
    v_add3_u32 v14, v14, v15, v6
    v_and_b32 v15, 1, v1
    v_lshl_add_u32 v14, v15, 3, v14
    v_lshlrev_b32 v14, 4, v14
    ds_write_b128 v11, v[96:99] offset:4608
    ds_write_b128 v11, v[100:103] offset:5904
    ds_write_b128 v11, v[104:107] offset:7200
    ds_write_b128 v11, v[108:111] offset:8496
    v_mov_b32 v13, 1
    s_mov_b64 exec, 1
    s_waitcnt lgkmcnt(0)
    ds_add_rtn_u32 v13, v12, v13
    s_mov_b64 exec, -1
    s_waitcnt lgkmcnt(0)
    v_readfirstlane_b32 s38, v13
    s_cmp_lg_u32 s38, 3
    s_cbranch_scc1 L_noqpub
    ds_read_b128 v[64:67], v14 offset:4608
    ds_read_b128 v[68:71], v14 offset:5312
    ds_read_b128 v[72:75], v14 offset:9792
    ds_read_b128 v[76:79], v14 offset:10496
    ds_read_b128 v[80:83], v14 offset:14976
    ds_read_b128 v[84:87], v14 offset:15680
    ds_read_b128 v[88:91], v14 offset:20160
    ds_read_b128 v[92:95], v14 offset:20864
    s_waitcnt lgkmcnt(6)
    v_pk_add_f32 v[64:65], v[64:65], v[68:69]
    v_pk_add_f32 v[66:67], v[66:67], v[70:71]
    s_waitcnt lgkmcnt(4)
    v_pk_add_f32 v[72:73], v[72:73], v[76:77]
    v_pk_add_f32 v[74:75], v[74:75], v[78:79]
    s_waitcnt lgkmcnt(2)
    v_pk_add_f32 v[80:81], v[80:81], v[84:85]
    v_pk_add_f32 v[82:83], v[82:83], v[86:87]
    s_waitcnt lgkmcnt(0)
    v_pk_add_f32 v[88:89], v[88:89], v[92:93]
    v_pk_add_f32 v[90:91], v[90:91], v[94:95]
    v_pk_add_f32 v[64:65], v[64:65], v[72:73]
    v_pk_add_f32 v[66:67], v[66:67], v[74:75]
    v_pk_add_f32 v[80:81], v[80:81], v[88:89]
    v_pk_add_f32 v[82:83], v[82:83], v[90:91]
    v_pk_add_f32 v[64:65], v[64:65], v[80:81]
    v_pk_add_f32 v[66:67], v[66:67], v[82:83]
    v_add_u32 v64, 0x80, v64
    v_add_u32 v65, 0x80, v65
    v_add_u32 v66, 0x80, v66
    v_add_u32 v67, 0x80, v67
    v_mov_b32_sdwa v64, s30 dst_sel:BYTE_0 dst_unused:UNUSED_PRESERVE src0_sel:BYTE_0
    v_mov_b32_sdwa v65, s30 dst_sel:BYTE_0 dst_unused:UNUSED_PRESERVE src0_sel:BYTE_1
    v_mov_b32_sdwa v66, s30 dst_sel:BYTE_0 dst_unused:UNUSED_PRESERVE src0_sel:BYTE_2
    v_mov_b32_sdwa v67, s30 dst_sel:BYTE_0 dst_unused:UNUSED_PRESERVE src0_sel:BYTE_3
    s_nop 0
    global_store_dwordx4 v54, v[64:67], s[50:51]
    v_add_u32 v54, 262144, v54
    global_store_dwordx4 v54, v[64:67], s[50:51] sc1
    v_mov_b32 v13, 1
    s_mov_b64 exec, 1
    ds_add_u32 v12, v13
    s_mov_b64 exec, -1
L_noqpub:
    s_lshl_b32 s54, s32, 5
    s_add_u32 s54, s54, s33
    s_lshl_b32 s54, s54, 11
    s_add_u32 s54, s54, 524544
    s_and_b32 s56, s33, 3
    s_lshl_b32 s56, s56, 3
    s_add_u32 s56, s56, s32
    s_lshl_b32 s56, s56, 3
    s_lshr_b32 s39, s33, 2
    s_add_u32 s56, s56, s39
    s_lshl_b32 s56, s56, 11
    s_add_u32 s56, s56, 1048832

    s_add_u32 s54, s28, s54
    s_addc_u32 s55, s29, 0
    s_add_u32 s56, s28, s56
    s_addc_u32 s57, s29, 0
    v_lshrrev_b32 v10, 5, v0
    v_lshlrev_b32 v10, 12, v10
    v_and_b32 v11, 31, v0
    v_lshl_add_u32 v10, v11, 4, v10
    s_lshl_b32 s38, s32, 2
    s_add_u32 s38, s38, s34
    s_lshl_b32 s38, s38, 13
    s_lshl_b32 s39, s36, 9
    s_add_u32 s38, s38, s39
    s_add_u32 s38, s38, 256
    s_add_u32 s50, s28, s38
    s_addc_u32 s51, s29, 0
    v_bfe_u32 v11, v0, 3, 2
    v_lshlrev_b32 v11, 6, v11
    v_lshrrev_b32 v12, 5, v0
    v_lshl_add_u32 v11, v12, 5, v11
    v_and_b32 v12, 7, v0
    v_lshl_add_u32 v11, v12, 1, v11
    s_mul_i32 s38, s36, 320
    v_add_u32 v11, s38, v11
    v_mov_b32 v15, 0xffffff00
    s_sleep 16
    s_mov_b32 s38, 200000
L_qpoll:
    global_load_dwordx4 v[16:19], v10, s[50:51] sc1
    global_load_dwordx4 v[20:23], v10, s[50:51] offset:2048 sc1
L_qchk:
    s_waitcnt vmcnt(0)
    v_perm_b32 v24, v17, v16, s42
    v_perm_b32 v25, v19, v18, s43
    v_or_b32 v24, v24, v25
    v_perm_b32 v26, v21, v20, s42
    v_perm_b32 v27, v23, v22, s43
    v_or_b32 v26, v26, v27
    v_cmp_ne_u32 vcc, s30, v24
    v_cmp_ne_u32 s[52:53], s30, v26
    s_or_b64 exec, vcc, s[52:53]
    s_cbranch_execz L_qdone
    s_sleep 4
    s_cmp_eq_u32 s38, 199984
    s_cselect_b32 s39, 262144, 0
    s_add_u32 s50, s50, s39
    s_addc_u32 s51, s51, 0
    s_sub_u32 s38, s38, 1
    s_cbranch_scc0 L_qpoll
L_qdone:
    s_mov_b64 exec, -1
    v_and_b32 v16, v15, v16
    v_and_b32 v17, v15, v17
    v_and_b32 v18, v15, v18
    v_and_b32 v19, v15, v19
    v_and_b32 v20, v15, v20
    v_and_b32 v21, v15, v21
    v_and_b32 v22, v15, v22
    v_and_b32 v23, v15, v23
    v_pk_add_f32 v[16:17], v[16:17], v[20:21]
    v_pk_add_f32 v[18:19], v[18:19], v[22:23]
    s_nop 1
    v_permlane32_swap_b32 v16, v18
    v_permlane32_swap_b32 v17, v19
    s_nop 0
    v_pk_add_f32 v[16:17], v[16:17], v[18:19]
    v_cvt_pk_bf16_f32 v16, v16, v17
    ds_write_b16 v11, v16 offset:25600
    ds_write_b16_d16_hi v11, v16 offset:25616
    v_lshrrev_b32 v4, 2, v1
    v_lshlrev_b32 v4, 5, v4
    v_mov_b32 v12, 44032
    v_mov_b32 v13, 1
    v_mov_b32 v43, s30
    s_waitcnt lgkmcnt(0)
    s_setprio 0
    s_barrier
    s_cmp_eq_u32 s36, 2
    s_cbranch_scc1 L_final
    s_cmp_eq_u32 s36, 3
    s_cbranch_scc1 L_B3
    s_mov_b32 s39, 200000
L_spinM:

    ds_read_b32 v13, v12 offset:12
    s_sub_u32 s39, s39, 1
    s_cbranch_scc1 L_spindM
    s_waitcnt lgkmcnt(0)
    v_readfirstlane_b32 s38, v13
    s_cmp_lt_u32 s38, 4
    s_cbranch_scc1 L_spinM
L_spindM:
    s_setprio 3
    ds_read_b128 v[8:11], v4 offset:35328
    ds_read_b128 v[12:15], v4 offset:35344
    s_waitcnt lgkmcnt(0)
    v_max3_f32 v42, v8, v10, v12
    v_max_f32 v42, v42, v14
    v_sub_f32 v8, v8, v42
    v_sub_f32 v10, v10, v42
    v_sub_f32 v12, v12, v42
    v_sub_f32 v14, v14, v42
    v_exp_f32 v8, v8
    v_exp_f32 v10, v10
    v_exp_f32 v12, v12
    v_exp_f32 v14, v14
    v_mul_f32 v9, v8, v9
    v_fmac_f32 v9, v10, v11
    v_fmac_f32 v9, v12, v13
    v_fmac_f32 v9, v14, v15
    v_rcp_f32 v34, v9
    v_log_f32 v35, v9
    v_mul_f32 v8, v8, v34
    v_mul_f32 v10, v10, v34
    v_mul_f32 v12, v12, v34
    v_mul_f32 v14, v14, v34
    v_add_f32 v42, v42, v35
    s_barrier
    ds_read_b128 v[16:19], v2 offset:27136
    ds_read_b128 v[20:23], v2 offset:29184
    ds_read_b128 v[24:27], v2 offset:31232
    ds_read_b128 v[28:31], v2 offset:33280
    s_waitcnt lgkmcnt(3)
    v_pk_mul_f32 v[16:17], v[16:17], v[8:9] op_sel_hi:[1,0]
    v_pk_mul_f32 v[18:19], v[18:19], v[8:9] op_sel_hi:[1,0]
    s_waitcnt lgkmcnt(2)
    v_pk_fma_f32 v[16:17], v[20:21], v[10:11], v[16:17] op_sel_hi:[1,0,1]
    v_pk_fma_f32 v[18:19], v[22:23], v[10:11], v[18:19] op_sel_hi:[1,0,1]
    s_waitcnt lgkmcnt(1)
    v_pk_fma_f32 v[16:17], v[24:25], v[12:13], v[16:17] op_sel_hi:[1,0,1]
    v_pk_fma_f32 v[18:19], v[26:27], v[12:13], v[18:19] op_sel_hi:[1,0,1]
    s_waitcnt lgkmcnt(0)
    v_pk_fma_f32 v[16:17], v[28:29], v[14:15], v[16:17] op_sel_hi:[1,0,1]
    v_pk_fma_f32 v[18:19], v[30:31], v[14:15], v[18:19] op_sel_hi:[1,0,1]
    v_cvt_pk_bf16_f32 v40, v16, v17
    v_cvt_pk_bf16_f32 v41, v18, v19
    global_store_dwordx4 v2, v[40:43], s[54:55]
    s_add_u32 s54, s54, 1048576
    s_addc_u32 s55, s55, 0
    global_store_dwordx4 v2, v[40:43], s[54:55] sc1
    s_barrier
    ds_read_b128 v[16:19], v2 offset:35584
    ds_read_b128 v[20:23], v2 offset:37632
    ds_read_b128 v[24:27], v2 offset:39680
    ds_read_b128 v[28:31], v2 offset:41728
    s_waitcnt lgkmcnt(2)
    v_pk_add_f32 v[16:17], v[16:17], v[20:21]
    v_pk_add_f32 v[18:19], v[18:19], v[22:23]
    s_waitcnt lgkmcnt(0)
    v_pk_add_f32 v[24:25], v[24:25], v[28:29]
    v_pk_add_f32 v[26:27], v[26:27], v[30:31]
    v_pk_add_f32 v[16:17], v[16:17], v[24:25]
    v_pk_add_f32 v[18:19], v[18:19], v[26:27]
    v_add_u32 v16, 0x80, v16
    v_add_u32 v17, 0x80, v17
    v_add_u32 v18, 0x80, v18
    v_add_u32 v19, 0x80, v19
    v_mov_b32_sdwa v16, s30 dst_sel:BYTE_0 dst_unused:UNUSED_PRESERVE src0_sel:BYTE_0
    v_mov_b32_sdwa v17, s30 dst_sel:BYTE_0 dst_unused:UNUSED_PRESERVE src0_sel:BYTE_1
    v_mov_b32_sdwa v18, s30 dst_sel:BYTE_0 dst_unused:UNUSED_PRESERVE src0_sel:BYTE_2
    v_mov_b32_sdwa v19, s30 dst_sel:BYTE_0 dst_unused:UNUSED_PRESERVE src0_sel:BYTE_3
    s_nop 0
    global_store_dwordx4 v2, v[16:19], s[56:57] sc1
    s_endpgm
L_B3:
    s_barrier
    s_barrier
    s_endpgm
L_final:
    v_and_b32 v8, 1, v0
    v_lshl_add_u32 v8, v6, 1, v8
    v_lshl_add_u32 v3, v8, 1, s47
    global_load_ushort v5, v3, s[4:5]
    v_lshlrev_b32 v8, 4, v8
    s_bfe_u32 s38, s47, 0x20008
    s_lshl_b32 s38, s38, 17
    s_lshr_b32 s39, s32, 1
    s_lshl_b32 s39, s39, 8
    s_add_u32 s38, s38, s39
    s_and_b32 s39, s47, 0xf0
    s_add_u32 s38, s38, s39
    s_add_u32 s38, s38, 1048832
    s_add_u32 s50, s28, s38
    s_addc_u32 s51, s29, 0
    v_lshlrev_b32 v10, 11, v0
    s_lshl_b32 s31, s31, 16
    s_barrier
    ds_read_b128 v[32:35], v8 offset:43776
    s_waitcnt lgkmcnt(0)
    v_add_f32 v32, v32, v33
    v_add_f32 v34, v34, v35
    v_add_f32 v32, v32, v34
    v_cvt_pk_bf16_f32 v32, 0, v32
    v_add_f32 v32, s31, v32
    v_cvt_pk_bf16_f32 v32, 0, v32
    v_mul_f32 v33, 0xbfb8aa3b, v32
    v_exp_f32 v33, v33
    s_nop 0
    v_add_f32 v33, 1.0, v33
    v_rcp_f32 v33, v33
    s_nop 0
    v_mul_f32 v32, v32, v33
    v_cvt_pk_bf16_f32 v32, 0, v32
    s_waitcnt vmcnt(0)
    v_lshlrev_b32 v4, 16, v5
    s_nop 1
    v_mov_b32_dpp v33, v32 quad_perm:[1,0,3,2] row_mask:0xf bank_mask:0xf
    v_mov_b32_dpp v5, v4 quad_perm:[1,0,3,2] row_mask:0xf bank_mask:0xf
    s_barrier
    s_sleep 18
    s_mov_b32 s38, 200000
    s_mov_b64 s[66:67], -1
    global_load_dwordx4 v[96:99], v10, s[50:51] sc1
    global_load_dwordx4 v[100:103], v10, s[50:51] offset:1024 sc1
    s_sleep 6
    global_load_dwordx4 v[104:107], v10, s[50:51] sc1
    global_load_dwordx4 v[108:111], v10, s[50:51] offset:1024 sc1
L_fpoll:
    s_waitcnt vmcnt(2)
    v_perm_b32 v44, v97, v96, s42
    v_perm_b32 v45, v99, v98, s43
    v_or_b32 v44, v44, v45
    v_perm_b32 v46, v101, v100, s42
    v_perm_b32 v47, v103, v102, s43
    v_or_b32 v46, v46, v47
    v_cmp_ne_u32 vcc, s30, v44
    v_cmp_ne_u32 s[52:53], s30, v46
    v_and_b32 v16, v15, v96
    v_and_b32 v17, v15, v97
    v_and_b32 v18, v15, v98
    v_and_b32 v19, v15, v99
    v_and_b32 v20, v15, v100
    v_and_b32 v21, v15, v101
    v_and_b32 v22, v15, v102
    v_and_b32 v23, v15, v103
    s_or_b64 exec, vcc, s[52:53]
    s_cbranch_execz L_fdone
    global_load_dwordx4 v[96:99], v10, s[50:51] sc1
    global_load_dwordx4 v[100:103], v10, s[50:51] offset:1024 sc1
    s_waitcnt vmcnt(2)
    v_perm_b32 v44, v105, v104, s42
    v_perm_b32 v45, v107, v106, s43
    v_or_b32 v44, v44, v45
    v_perm_b32 v46, v109, v108, s42
    v_perm_b32 v47, v111, v110, s43
    v_or_b32 v46, v46, v47
    v_cmp_ne_u32 vcc, s30, v44
    v_cmp_ne_u32 s[52:53], s30, v46
    v_and_b32 v16, v15, v104
    v_and_b32 v17, v15, v105
    v_and_b32 v18, v15, v106
    v_and_b32 v19, v15, v107
    v_and_b32 v20, v15, v108
    v_and_b32 v21, v15, v109
    v_and_b32 v22, v15, v110
    v_and_b32 v23, v15, v111
    s_or_b64 exec, vcc, s[52:53]
    s_cbranch_execz L_fdone
    global_load_dwordx4 v[104:107], v10, s[50:51] sc1
    global_load_dwordx4 v[108:111], v10, s[50:51] offset:1024 sc1
    s_sub_u32 s38, s38, 1
    s_cbranch_scc0 L_fpoll
L_fdone:
    s_mov_b64 exec, -1
    v_permlane32_swap_b32 v16, v20
    v_permlane32_swap_b32 v17, v21
    v_permlane32_swap_b32 v18, v22
    v_permlane32_swap_b32 v19, v23
    v_add_f32 v16, v16, v20
    v_add_f32 v17, v17, v21
    v_add_f32 v18, v18, v22
    v_add_f32 v19, v19, v23
    s_mov_b32 vcc_lo, 0xAAAAAAAA
    v_permlane16_swap_b32 v16, v18
    v_permlane16_swap_b32 v17, v19
    s_mov_b32 vcc_hi, 0xAAAAAAAA
    v_add_f32 v16, v16, v18
    v_add_f32 v17, v17, v19
    s_nop 0
    v_add_f32_dpp v16, v16, v16 row_ror:8 row_mask:0xf bank_mask:0xf
    v_add_f32_dpp v17, v17, v17 row_ror:8 row_mask:0xf bank_mask:0xf
    s_nop 0
    v_add_f32_dpp v16, v16, v16 row_ror:4 row_mask:0xf bank_mask:0xf
    v_add_f32_dpp v17, v17, v17 row_ror:4 row_mask:0xf bank_mask:0xf
    s_nop 0
    v_add_f32_dpp v16, v16, v16 row_ror:2 row_mask:0xf bank_mask:0xf
    v_add_f32_dpp v17, v17, v17 row_ror:2 row_mask:0xf bank_mask:0xf
    s_nop 0
    v_add_f32_dpp v16, v16, v16 row_ror:1 row_mask:0xf bank_mask:0xf
    v_add_f32_dpp v17, v17, v17 row_ror:1 row_mask:0xf bank_mask:0xf
    v_cvt_pk_bf16_f32 v16, 0, v16
    v_cvt_pk_bf16_f32 v17, 0, v17
    s_mov_b32 exec_lo, 0x00010001
    v_pk_mul_f32 v[16:17], v[16:17], v[32:33]
    s_mov_b32 exec_hi, 0x00010001
    v_cvt_pk_bf16_f32 v16, 0, v16
    v_cvt_pk_bf16_f32 v17, 0, v17
    v_pk_add_f32 v[16:17], v[16:17], v[4:5]
    v_cvt_pk_bf16_f32 v16, v16, v17
    global_store_dword v3, v16, s[24:25]
    s_cmp_lg_u32 s2, 0
    s_cbranch_scc1 L_noep
    s_mov_b64 exec, 1
    v_mov_b32 v0, 0
    v_mov_b32 v1, s30
    global_store_dword v0, v1, s[28:29]
L_noep:
    s_endpgm
L_A:
    v_lshrrev_b32 v9, 2, v1
    v_mul_u32_u24 v7, 320, v9
    v_lshl_add_u32 v7, v6, 4, v7

    s_lshl_b32 s38, s37, 11
    v_lshlrev_b32 v11, 4, v0
    v_add_u32 v11, s38, v11
    s_lshl_b32 s38, s37, 3
    v_lshlrev_b32 v12, 5, v9
    v_add_u32 v12, s38, v12
    v_and_b32 v13, 3, v1
    v_lshlrev_b32 v10, 12, v13
    v_lshl_add_u32 v10, v9, 14, v10
    v_lshl_add_u32 v10, v6, 4, v10
    s_lshl_b32 s66, s32, 16
    s_lshl_b32 s67, s46, 7
    s_add_u32 s66, s66, s67
    s_lshr_b32 s67, s37, 1
    s_lshl_b32 s67, s67, 10
    s_add_u32 s66, s66, s67
    s_and_b32 s67, s37, 1
    s_lshl_b32 s67, s67, 6
    s_add_u32 s66, s66, s67
    s_add_u32 s66, s66, 524544
    s_add_u32 s50, s28, s66
    s_addc_u32 s51, s29, 0
    s_mov_b32 s58, 0x11111111
    s_mov_b32 s59, 0x11111111
    s_mov_b32 s60, 0x22222222
    s_mov_b32 s61, 0x22222222
    s_mov_b32 s62, 0x44444444
    s_mov_b32 s63, 0x44444444
    s_mov_b32 s64, 0x88888888
    s_mov_b32 s65, 0x88888888
    s_mov_b32 s68, 0x3db504f3
    s_mov_b32 s69, 0x3fb8aa3b
    v_mov_b32 v14, 44032
    s_mov_b32 s39, 200000
L_spinF:
    s_sleep 1
    ds_read_b32 v13, v14 offset:0
    s_sub_u32 s39, s39, 1
    s_cbranch_scc1 L_spindF
    s_waitcnt lgkmcnt(0)
    v_readfirstlane_b32 s38, v13
    s_cmp_lt_u32 s38, 5
    s_cbranch_scc1 L_spinF
L_spindF:
    global_load_dwordx4 v[32:35], v3, s[70:71] offset:0 nt
    global_load_dwordx4 v[36:39], v3, s[70:71] offset:64 nt
    global_load_dwordx4 v[40:43], v3, s[70:71] offset:128 nt
    global_load_dwordx4 v[44:47], v3, s[70:71] offset:192 nt
    global_load_dwordx4 v[48:51], v4, s[8:9] offset:0 nt
    global_load_dwordx4 v[52:55], v4, s[8:9] offset:256 nt
    global_load_dwordx4 v[56:59], v4, s[8:9] offset:512 nt
    global_load_dwordx4 v[60:63], v4, s[8:9] offset:768 nt
    s_waitcnt vmcnt(7)
    global_load_dwordx4 v[64:67], v4, s[72:73] offset:0 nt
    global_load_dwordx4 v[68:71], v4, s[72:73] offset:256 nt
    global_load_dwordx4 v[72:75], v4, s[72:73] offset:512 nt
    global_load_dwordx4 v[76:79], v4, s[72:73] offset:768 nt
    s_waitcnt lgkmcnt(0)
    s_mul_i32 s30, s30, 0x9E3779B1
    s_add_u32 s30, s30, 0x7F4A7C15
    s_or_b32 s30, s30, 1
    s_waitcnt vmcnt(4)
    v_perm_b32 v96, v52, v48, s40
    v_perm_b32 v97, v60, v56, s40
    v_perm_b32 v100, v52, v48, s41
    v_perm_b32 v101, v60, v56, s41
    v_perm_b32 v104, v53, v49, s40
    v_perm_b32 v105, v61, v57, s40
    v_perm_b32 v108, v53, v49, s41
    v_perm_b32 v109, v61, v57, s41
    v_perm_b32 v112, v54, v50, s40
    v_perm_b32 v113, v62, v58, s40
    v_perm_b32 v116, v54, v50, s41
    v_perm_b32 v117, v62, v58, s41
    v_perm_b32 v120, v55, v51, s40
    v_perm_b32 v121, v63, v59, s40
    v_perm_b32 v124, v55, v51, s41
    v_perm_b32 v125, v63, v59, s41
    v_mov_b32 v14, 44032
    v_mov_b32 v13, 1
    s_setprio 2
    s_barrier
    ds_read_b128 v[128:131], v7 offset:25600
    ds_read_b128 v[132:135], v7 offset:25664
    ds_read_b128 v[136:139], v7 offset:25728
    ds_read_b128 v[140:143], v7 offset:25792
    s_waitcnt lgkmcnt(3)
    v_mfma_f32_16x16x32_bf16 v[144:147], v[16:19], v[128:131], 0
    v_mfma_f32_16x16x32_bf16 v[148:151], v[32:35], v[128:131], 0
    s_waitcnt lgkmcnt(2)
    v_mfma_f32_16x16x32_bf16 v[144:147], v[20:23], v[132:135], v[144:147]
    v_mfma_f32_16x16x32_bf16 v[148:151], v[36:39], v[132:135], v[148:151]
    s_waitcnt lgkmcnt(1)
    v_mfma_f32_16x16x32_bf16 v[144:147], v[24:27], v[136:139], v[144:147]
    v_mfma_f32_16x16x32_bf16 v[148:151], v[40:43], v[136:139], v[148:151]
    s_waitcnt lgkmcnt(0)
    v_mfma_f32_16x16x32_bf16 v[144:147], v[28:31], v[140:143], v[144:147]
    v_mfma_f32_16x16x32_bf16 v[148:151], v[44:47], v[140:143], v[148:151]
    s_nop 6
    v_max3_f32 v156, v144, v145, v146
    v_max3_f32 v157, v147, v148, v149
    v_max3_f32 v156, v156, v150, v151
    v_max_f32 v156, v156, v157
    v_mov_b32 v157, v156
    v_cvt_pk_bf16_f32 v144, 0, v144
    v_cvt_pk_bf16_f32 v145, 0, v145
    v_permlane16_swap_b32 v156, v157
    v_cvt_pk_bf16_f32 v146, 0, v146
    v_cvt_pk_bf16_f32 v147, 0, v147
    v_max_f32 v156, v156, v157
    v_mov_b32 v157, v156
    v_cvt_pk_bf16_f32 v148, 0, v148
    v_cvt_pk_bf16_f32 v149, 0, v149
    v_permlane32_swap_b32 v156, v157
    v_cvt_pk_bf16_f32 v150, 0, v150
    v_cvt_pk_bf16_f32 v151, 0, v151
    v_max_f32 v156, v156, v157
    v_pk_mul_f32 v[144:145], v[144:145], s[68:69] op_sel_hi:[1,0]
    v_cvt_pk_bf16_f32 v156, 0, v156
    v_pk_mul_f32 v[146:147], v[146:147], s[68:69] op_sel_hi:[1,0]
    v_mul_f32 v156, s68, v156
    v_pk_mul_f32 v[148:149], v[148:149], s[68:69] op_sel_hi:[1,0]
    v_cvt_pk_bf16_f32 v156, 0, v156
    v_pk_mul_f32 v[150:151], v[150:151], s[68:69] op_sel_hi:[1,0]
    v_mul_f32 v156, s69, v156
    v_cvt_pk_bf16_f32 v144, 0, v144
    v_cvt_pk_bf16_f32 v145, 0, v145
    v_cvt_pk_bf16_f32 v146, 0, v146
    v_cvt_pk_bf16_f32 v147, 0, v147
    v_cvt_pk_bf16_f32 v148, 0, v148
    v_cvt_pk_bf16_f32 v149, 0, v149
    v_cvt_pk_bf16_f32 v150, 0, v150
    v_cvt_pk_bf16_f32 v151, 0, v151
    v_pk_fma_f32 v[144:145], v[144:145], s[68:69], v[156:157] op_sel:[0,1,0] op_sel_hi:[1,1,0] neg_lo:[0,0,1] neg_hi:[0,0,1]
    v_pk_fma_f32 v[146:147], v[146:147], s[68:69], v[156:157] op_sel:[0,1,0] op_sel_hi:[1,1,0] neg_lo:[0,0,1] neg_hi:[0,0,1]
    v_pk_fma_f32 v[148:149], v[148:149], s[68:69], v[156:157] op_sel:[0,1,0] op_sel_hi:[1,1,0] neg_lo:[0,0,1] neg_hi:[0,0,1]
    v_pk_fma_f32 v[150:151], v[150:151], s[68:69], v[156:157] op_sel:[0,1,0] op_sel_hi:[1,1,0] neg_lo:[0,0,1] neg_hi:[0,0,1]
    v_exp_f32 v144, v144
    v_exp_f32 v145, v145
    v_exp_f32 v146, v146
    v_exp_f32 v147, v147
    v_exp_f32 v148, v148
    v_exp_f32 v149, v149
    v_exp_f32 v150, v150
    v_exp_f32 v151, v151
    v_cvt_pk_bf16_f32 v152, v144, v145
    v_cvt_pk_bf16_f32 v153, v146, v147
    v_cvt_pk_bf16_f32 v154, v148, v149
    v_cvt_pk_bf16_f32 v155, v150, v151
    v_pk_add_f32 v[144:145], v[144:145], v[146:147]
    v_pk_add_f32 v[148:149], v[148:149], v[150:151]
    v_pk_add_f32 v[144:145], v[144:145], v[148:149]
    v_add_f32 v157, v144, v145
    v_mov_b32 v158, v157
    v_cndmask_b32 v128, 0, v152, s[58:59]
    v_cndmask_b32 v129, 0, v153, s[58:59]
    v_cndmask_b32 v130, 0, v154, s[58:59]
    v_cndmask_b32 v131, 0, v155, s[58:59]
    v_permlane16_swap_b32 v157, v158
    v_cndmask_b32 v132, 0, v152, s[60:61]
    v_add_f32 v157, v157, v158
    v_mov_b32 v158, v157
    v_cndmask_b32 v133, 0, v153, s[60:61]
    v_cndmask_b32 v134, 0, v154, s[60:61]
    v_cndmask_b32 v135, 0, v155, s[60:61]
    v_permlane32_swap_b32 v157, v158
    v_cndmask_b32 v136, 0, v152, s[62:63]
    v_add_f32 v157, v157, v158
    s_mov_b64 exec, 0x1111
    ds_write_b64 v12, v[156:157] offset:35328
    s_mov_b64 exec, 1
    ds_add_u32 v14, v13 offset:12
    s_mov_b64 exec, -1
    v_cndmask_b32 v137, 0, v153, s[62:63]
    v_cndmask_b32 v138, 0, v154, s[62:63]
    v_cndmask_b32 v139, 0, v155, s[62:63]
    v_cndmask_b32 v140, 0, v152, s[64:65]
    v_cndmask_b32 v141, 0, v153, s[64:65]
    v_cndmask_b32 v142, 0, v154, s[64:65]
    v_cndmask_b32 v143, 0, v155, s[64:65]
    s_waitcnt vmcnt(0)
    global_load_dwordx4 v[80:83], v5, s[12:13] nt
    v_add_u32 v5, 0x2000, v5
    global_load_dwordx4 v[84:87], v5, s[12:13] nt
    v_add_u32 v5, 0x2000, v5
    global_load_dwordx4 v[88:91], v5, s[12:13] nt
    v_add_u32 v5, 0x2000, v5
    global_load_dwordx4 v[92:95], v5, s[12:13] nt
    v_perm_b32 v98, v68, v64, s40
    v_perm_b32 v99, v76, v72, s40
    v_perm_b32 v102, v68, v64, s41
    v_perm_b32 v103, v76, v72, s41
    v_mfma_f32_16x16x32_bf16 v[16:19], v[96:99], v[128:131], 0
    v_perm_b32 v106, v69, v65, s40
    v_perm_b32 v107, v77, v73, s40
    v_mfma_f32_16x16x32_bf16 v[16:19], v[100:103], v[132:135], v[16:19]
    v_perm_b32 v110, v69, v65, s41
    v_perm_b32 v111, v77, v73, s41
    v_mfma_f32_16x16x32_bf16 v[16:19], v[104:107], v[136:139], v[16:19]
    v_perm_b32 v114, v70, v66, s40
    v_perm_b32 v115, v78, v74, s40
    v_mfma_f32_16x16x32_bf16 v[16:19], v[108:111], v[140:143], v[16:19]
    v_perm_b32 v118, v70, v66, s41
    v_perm_b32 v119, v78, v74, s41
    v_mfma_f32_16x16x32_bf16 v[20:23], v[112:115], v[128:131], 0
    v_perm_b32 v122, v71, v67, s40
    v_perm_b32 v123, v79, v75, s40
    v_mfma_f32_16x16x32_bf16 v[20:23], v[116:119], v[132:135], v[20:23]
    v_perm_b32 v126, v71, v67, s41
    v_perm_b32 v127, v79, v75, s41
    v_mfma_f32_16x16x32_bf16 v[20:23], v[120:123], v[136:139], v[20:23]
    ds_write_b128 v11, v[16:19] offset:27136
    v_mfma_f32_16x16x32_bf16 v[20:23], v[124:127], v[140:143], v[20:23]
    s_nop 7
    ds_write_b128 v11, v[20:23] offset:28160
    s_waitcnt lgkmcnt(0)
    s_barrier
    s_sleep 8
    s_mov_b32 s38, 200000
    global_load_dwordx4 v[16:19], v10, s[50:51] sc1
    global_load_dwordx4 v[20:23], v10, s[50:51] offset:2048 sc1
    s_waitcnt vmcnt(2)
    v_perm_b32 v96, v84, v80, s40
    v_perm_b32 v97, v92, v88, s40
    v_perm_b32 v98, v84, v80, s41
    v_perm_b32 v99, v92, v88, s41
    v_perm_b32 v100, v85, v81, s40
    v_perm_b32 v101, v93, v89, s40
    v_perm_b32 v102, v85, v81, s41
    v_perm_b32 v103, v93, v89, s41
    v_perm_b32 v104, v86, v82, s40
    v_perm_b32 v105, v94, v90, s40
    v_perm_b32 v106, v86, v82, s41
    v_perm_b32 v107, v94, v90, s41
    v_perm_b32 v108, v87, v83, s40
    v_perm_b32 v109, v95, v91, s40
    v_perm_b32 v110, v87, v83, s41
    v_perm_b32 v111, v95, v91, s41
    s_branch L_ochk
L_opoll:
    global_load_dwordx4 v[16:19], v10, s[50:51] sc1
    global_load_dwordx4 v[20:23], v10, s[50:51] offset:2048 sc1
L_ochk:
    s_waitcnt vmcnt(0)
    v_cmp_ne_u32 vcc, s30, v19
    v_cmp_ne_u32 s[52:53], s30, v23
    s_or_b64 exec, vcc, s[52:53]
    s_cbranch_execz L_odone
    s_sleep 1
    s_cmp_eq_u32 s38, 199984
    s_cselect_b32 s39, 1048576, 0
    s_add_u32 s50, s50, s39
    s_addc_u32 s51, s51, 0
    s_sub_u32 s38, s38, 1
    s_cbranch_scc0 L_opoll
L_odone:
    s_mov_b64 exec, -1
    v_max_f32 v24, v18, v22
    v_lshlrev_b32 v26, 16, v16
    v_and_b32 v27, 0xffff0000, v16
    v_max_f32_dpp v24, v24, v24 quad_perm:[1,0,3,2] row_mask:0xf bank_mask:0xf
    v_lshlrev_b32 v28, 16, v17
    v_and_b32 v29, 0xffff0000, v17
    v_max_f32_dpp v24, v24, v24 quad_perm:[2,3,0,1] row_mask:0xf bank_mask:0xf
    v_lshlrev_b32 v30, 16, v20
    v_sub_f32 v18, v18, v24
    v_sub_f32 v22, v22, v24
    v_exp_f32 v18, v18
    v_and_b32 v31, 0xffff0000, v20
    v_exp_f32 v22, v22
    v_lshlrev_b32 v32, 16, v21
    v_and_b32 v33, 0xffff0000, v21
    v_add_f32 v24, v18, v22
    v_pk_mul_f32 v[26:27], v[26:27], v[18:19] op_sel_hi:[1,0]
    v_pk_mul_f32 v[28:29], v[28:29], v[18:19] op_sel_hi:[1,0]
    v_add_f32_dpp v24, v24, v24 quad_perm:[1,0,3,2] row_mask:0xf bank_mask:0xf
    v_pk_fma_f32 v[26:27], v[30:31], v[22:23], v[26:27] op_sel_hi:[1,0,1]
    v_pk_fma_f32 v[28:29], v[32:33], v[22:23], v[28:29] op_sel_hi:[1,0,1]
    v_add_f32_dpp v24, v24, v24 quad_perm:[2,3,0,1] row_mask:0xf bank_mask:0xf
    v_add_f32_dpp v26, v26, v26 quad_perm:[1,0,3,2] row_mask:0xf bank_mask:0xf
    v_rcp_f32 v24, v24
    v_add_f32_dpp v27, v27, v27 quad_perm:[1,0,3,2] row_mask:0xf bank_mask:0xf
    v_add_f32_dpp v28, v28, v28 quad_perm:[1,0,3,2] row_mask:0xf bank_mask:0xf
    v_add_f32_dpp v29, v29, v29 quad_perm:[1,0,3,2] row_mask:0xf bank_mask:0xf
    v_add_f32_dpp v26, v26, v26 quad_perm:[2,3,0,1] row_mask:0xf bank_mask:0xf
    v_add_f32_dpp v27, v27, v27 quad_perm:[2,3,0,1] row_mask:0xf bank_mask:0xf
    v_add_f32_dpp v28, v28, v28 quad_perm:[2,3,0,1] row_mask:0xf bank_mask:0xf
    v_add_f32_dpp v29, v29, v29 quad_perm:[2,3,0,1] row_mask:0xf bank_mask:0xf
    v_pk_mul_f32 v[26:27], v[26:27], v[24:25] op_sel_hi:[1,0]
    v_pk_mul_f32 v[28:29], v[28:29], v[24:25] op_sel_hi:[1,0]
    v_cvt_pk_bf16_f32 v8, v26, v27
    v_cvt_pk_bf16_f32 v9, v28, v29
    v_cndmask_b32 v40, 0, v8, s[58:59]
    v_cndmask_b32 v41, 0, v9, s[58:59]
    v_cndmask_b32 v42, 0, v8, s[60:61]
    v_cndmask_b32 v43, 0, v9, s[60:61]
    v_cndmask_b32 v44, 0, v8, s[62:63]
    v_cndmask_b32 v45, 0, v9, s[62:63]
    v_cndmask_b32 v46, 0, v8, s[64:65]
    v_cndmask_b32 v47, 0, v9, s[64:65]
    v_mfma_f32_16x16x32_bf16 v[128:131], v[40:43], v[96:99], 0
    v_mfma_f32_16x16x32_bf16 v[132:135], v[40:43], v[104:107], 0
    v_mfma_f32_16x16x32_bf16 v[128:131], v[44:47], v[100:103], v[128:131]
    v_mfma_f32_16x16x32_bf16 v[132:135], v[44:47], v[108:111], v[132:135]
    s_nop 6
    ds_write_b128 v11, v[128:131] offset:35584
    ds_write_b128 v11, v[132:135] offset:36608
    s_waitcnt lgkmcnt(0)
    s_barrier
    s_endpgm
L_C:
    s_lshr_b32 s38, s32, 1
    s_mul_i32 s38, s38, 1088
    v_lshl_add_u32 v7, v1, 4, s38
    s_and_b32 s39, s47, 0x3ff
    s_add_u32 s38, s38, s39
    v_and_b32 v8, 7, v0
    v_lshl_add_u32 v8, v8, 1, s38
    s_mov_b32 s44, 0x3b000000
    s_mov_b32 s45, 0x3727c5ac
    s_mov_b32 s48, 0x3f803f80
    v_mov_b32 v24, 0
    v_mov_b32 v25, 0
    v_mov_b32 v26, 0
    v_mov_b32 v27, 0
    s_sleep 8
    s_mov_b32 s39, 200000
L_spinC:
    s_sleep 1
    ds_read_b32 v13, v12 offset:4
    s_sub_u32 s39, s39, 1
    s_cbranch_scc1 L_spindC
    s_waitcnt lgkmcnt(0)
    v_readfirstlane_b32 s38, v13
    s_cmp_lt_u32 s38, 4
    s_cbranch_scc1 L_spinC
L_spindC:
    ds_read_b128 v[56:59], v7 offset:0
    ds_read_b128 v[60:63], v7 offset:256
    ds_read_b128 v[64:67], v7 offset:512
    ds_read_b128 v[68:71], v7 offset:768
    ds_read_u16 v28, v8 offset:0
    s_waitcnt lgkmcnt(0)
    v_dot2c_f32_bf16 v24, s48, v56
    v_dot2c_f32_bf16 v26, v56, v56
    v_dot2c_f32_bf16 v25, s48, v57
    v_dot2c_f32_bf16 v27, v57, v57
    v_dot2c_f32_bf16 v24, s48, v58
    v_dot2c_f32_bf16 v26, v58, v58
    v_dot2c_f32_bf16 v25, s48, v59
    v_dot2c_f32_bf16 v27, v59, v59
    v_dot2c_f32_bf16 v24, s48, v60
    v_dot2c_f32_bf16 v26, v60, v60
    v_dot2c_f32_bf16 v25, s48, v61
    v_dot2c_f32_bf16 v27, v61, v61
    v_dot2c_f32_bf16 v24, s48, v62
    v_dot2c_f32_bf16 v26, v62, v62
    v_dot2c_f32_bf16 v25, s48, v63
    v_dot2c_f32_bf16 v27, v63, v63
    v_dot2c_f32_bf16 v24, s48, v64
    v_dot2c_f32_bf16 v26, v64, v64
    v_dot2c_f32_bf16 v25, s48, v65
    v_dot2c_f32_bf16 v27, v65, v65
    v_dot2c_f32_bf16 v24, s48, v66
    v_dot2c_f32_bf16 v26, v66, v66
    v_dot2c_f32_bf16 v25, s48, v67
    v_dot2c_f32_bf16 v27, v67, v67
    v_dot2c_f32_bf16 v24, s48, v68
    v_dot2c_f32_bf16 v26, v68, v68
    v_dot2c_f32_bf16 v25, s48, v69
    v_dot2c_f32_bf16 v27, v69, v69
    v_dot2c_f32_bf16 v24, s48, v70
    v_dot2c_f32_bf16 v26, v70, v70
    v_dot2c_f32_bf16 v25, s48, v71
    v_dot2c_f32_bf16 v27, v71, v71
    v_lshlrev_b32 v28, 16, v28
    s_nop 1
    v_add_f32 v24, v24, v25
    v_add_f32 v26, v26, v27
    s_nop 0
    v_add_f32_dpp v24, v24, v24 row_ror:8 row_mask:0xf bank_mask:0xf
    v_add_f32_dpp v26, v26, v26 row_ror:8 row_mask:0xf bank_mask:0xf
    s_nop 0
    v_add_f32_dpp v24, v24, v24 row_ror:4 row_mask:0xf bank_mask:0xf
    v_add_f32_dpp v26, v26, v26 row_ror:4 row_mask:0xf bank_mask:0xf
    s_nop 0
    v_add_f32_dpp v24, v24, v24 row_ror:2 row_mask:0xf bank_mask:0xf
    v_add_f32_dpp v26, v26, v26 row_ror:2 row_mask:0xf bank_mask:0xf
    s_nop 0
    v_add_f32_dpp v24, v24, v24 row_ror:1 row_mask:0xf bank_mask:0xf
    v_add_f32_dpp v26, v26, v26 row_ror:1 row_mask:0xf bank_mask:0xf
    v_mul_f32 v24, s44, v24
    v_mul_f32 v26, s44, v26
    v_fma_f32 v26, -v24, v24, v26
    v_max_f32 v26, 0, v26
    v_cvt_pk_bf16_f32 v24, 0, v24
    v_cvt_pk_bf16_f32 v26, 0, v26
    v_add_f32 v26, s45, v26
    v_sub_f32 v28, v28, v24
    v_cvt_pk_bf16_f32 v26, 0, v26
    v_sqrt_f32 v26, v26
    v_cvt_pk_bf16_f32 v28, 0, v28
    v_cvt_pk_bf16_f32 v26, 0, v26
    v_rcp_f32 v26, v26
    s_nop 0
    v_mul_f32 v28, v28, v26
    v_cvt_pk_bf16_f32 v28, 0, v28
    s_cmp_ge_u32 s36, 10
    s_cbranch_scc1 L_cw0
    s_waitcnt vmcnt(2)
    s_branch L_cw1
L_cw0:
    s_waitcnt vmcnt(0)
L_cw1:
    v_lshlrev_b32 v32, 16, v80
    v_and_b32 v33, 0xffff0000, v80
    v_lshlrev_b32 v34, 16, v81
    v_and_b32 v35, 0xffff0000, v81
    v_lshlrev_b32 v36, 16, v82
    v_and_b32 v37, 0xffff0000, v82
    v_lshlrev_b32 v38, 16, v83
    v_and_b32 v39, 0xffff0000, v83
    v_lshlrev_b32 v40, 16, v84
    v_and_b32 v41, 0xffff0000, v84
    v_lshlrev_b32 v42, 16, v85
    v_and_b32 v43, 0xffff0000, v85
    v_lshlrev_b32 v44, 16, v86
    v_and_b32 v45, 0xffff0000, v86
    v_lshlrev_b32 v46, 16, v87
    v_and_b32 v47, 0xffff0000, v87
    v_lshlrev_b32 v48, 16, v88
    v_and_b32 v49, 0xffff0000, v88
    v_lshlrev_b32 v50, 16, v89
    v_and_b32 v51, 0xffff0000, v89
    v_lshlrev_b32 v52, 16, v90
    v_and_b32 v53, 0xffff0000, v90
    v_lshlrev_b32 v54, 16, v91
    v_and_b32 v55, 0xffff0000, v91
    v_readlane_b32 s64, v28, 0
    v_readlane_b32 s65, v28, 1
    v_readlane_b32 s66, v28, 2
    v_readlane_b32 s67, v28, 3
    v_readlane_b32 s68, v28, 4
    v_readlane_b32 s69, v28, 5
    v_readlane_b32 s70, v28, 6
    v_readlane_b32 s71, v28, 7
    s_mov_b32 s44, 0xbdd2d3e8
    v_mov_b32 v14, 0xc0135761
    s_mov_b32 s46, 0
L_gate:
    s_mov_b32 m0, s46
    s_nop 0
    s_movrels_b32 s72, s64
    v_pk_fma_f32 v[56:57], s[72:73], v[32:33], v[40:41] op_sel_hi:[0,1,1]
    v_pk_fma_f32 v[58:59], s[72:73], v[34:35], v[42:43] op_sel_hi:[0,1,1]
    v_pk_fma_f32 v[60:61], s[72:73], v[36:37], v[44:45] op_sel_hi:[0,1,1]
    v_pk_fma_f32 v[62:63], s[72:73], v[38:39], v[46:47] op_sel_hi:[0,1,1]
    v_pk_mul_f32 v[64:65], v[56:57], v[56:57]
    v_pk_mul_f32 v[66:67], v[58:59], v[58:59]
    v_pk_mul_f32 v[68:69], v[60:61], v[60:61]
    v_pk_mul_f32 v[70:71], v[62:63], v[62:63]
    v_pk_fma_f32 v[64:65], v[64:65], s[44:45], v[14:15] op_sel_hi:[1,0,0]
    v_pk_fma_f32 v[66:67], v[66:67], s[44:45], v[14:15] op_sel_hi:[1,0,0]
    v_pk_fma_f32 v[68:69], v[68:69], s[44:45], v[14:15] op_sel_hi:[1,0,0]
    v_pk_fma_f32 v[70:71], v[70:71], s[44:45], v[14:15] op_sel_hi:[1,0,0]
    v_pk_mul_f32 v[64:65], v[64:65], v[56:57]
    v_pk_mul_f32 v[66:67], v[66:67], v[58:59]
    v_pk_mul_f32 v[68:69], v[68:69], v[60:61]
    v_pk_mul_f32 v[70:71], v[70:71], v[62:63]
    v_exp_f32 v64, v64
    v_exp_f32 v65, v65
    v_exp_f32 v66, v66
    v_exp_f32 v67, v67
    v_exp_f32 v68, v68
    v_exp_f32 v69, v69
    v_exp_f32 v70, v70
    v_exp_f32 v71, v71
    v_pk_mul_f32 v[56:57], v[56:57], v[48:49]
    v_pk_mul_f32 v[58:59], v[58:59], v[50:51]
    v_pk_mul_f32 v[60:61], v[60:61], v[52:53]
    v_pk_mul_f32 v[62:63], v[62:63], v[54:55]
    v_pk_add_f32 v[64:65], v[64:65], 1.0 op_sel_hi:[1,0]
    v_pk_add_f32 v[66:67], v[66:67], 1.0 op_sel_hi:[1,0]
    v_pk_add_f32 v[68:69], v[68:69], 1.0 op_sel_hi:[1,0]
    v_pk_add_f32 v[70:71], v[70:71], 1.0 op_sel_hi:[1,0]
    v_rcp_f32 v64, v64
    v_rcp_f32 v65, v65
    v_rcp_f32 v66, v66
    v_rcp_f32 v67, v67
    v_rcp_f32 v68, v68
    v_rcp_f32 v69, v69
    v_rcp_f32 v70, v70
    v_rcp_f32 v71, v71
    v_pk_mul_f32 v[72:73], v[56:57], v[64:65]
    v_pk_fma_f32 v[72:73], v[58:59], v[66:67], v[72:73]
    v_pk_fma_f32 v[72:73], v[60:61], v[68:69], v[72:73]
    v_pk_fma_f32 v[72:73], v[62:63], v[70:71], v[72:73]
    s_set_gpr_idx_on s46, gpr_idx(DST)
    s_nop 0
    v_add_f32 v16, v72, v73
    s_set_gpr_idx_off
    s_add_u32 s46, s46, 1
    s_cmp_lt_u32 s46, 8
    s_cbranch_scc1 L_gate
    v_permlane32_swap_b32 v16, v20
    v_permlane32_swap_b32 v17, v21
    v_permlane32_swap_b32 v18, v22
    v_permlane32_swap_b32 v19, v23
    v_add_f32 v16, v16, v20
    v_add_f32 v17, v17, v21
    v_add_f32 v18, v18, v22
    v_add_f32 v19, v19, v23
    s_mov_b32 vcc_lo, 0xAAAAAAAA
    v_permlane16_swap_b32 v16, v18
    v_permlane16_swap_b32 v17, v19
    s_mov_b32 vcc_hi, 0xAAAAAAAA
    v_add_f32 v16, v16, v18
    v_add_f32 v17, v17, v19
    s_nop 0
    v_add_f32_dpp v16, v16, v16 row_ror:8 row_mask:0xf bank_mask:0xf
    v_add_f32_dpp v17, v17, v17 row_ror:8 row_mask:0xf bank_mask:0xf
    s_nop 0
    v_add_f32_dpp v16, v16, v16 row_ror:4 row_mask:0xf bank_mask:0xf
    v_add_f32_dpp v17, v17, v17 row_ror:4 row_mask:0xf bank_mask:0xf
    s_nop 0
    v_add_f32_dpp v16, v16, v16 row_ror:2 row_mask:0xf bank_mask:0xf
    v_add_f32_dpp v17, v17, v17 row_ror:2 row_mask:0xf bank_mask:0xf
    s_nop 0
    v_add_f32_dpp v16, v16, v16 row_ror:1 row_mask:0xf bank_mask:0xf
    v_add_f32_dpp v17, v17, v17 row_ror:1 row_mask:0xf bank_mask:0xf
    v_cndmask_b32 v16, v16, v17, vcc
    v_and_b32 v8, 1, v0
    v_lshl_add_u32 v8, v6, 1, v8
    v_lshlrev_b32 v8, 4, v8
    s_lshl_b32 s38, s37, 2
    v_add_u32 v9, s38, v8
    ds_write_b32 v9, v16 offset:43776
    s_waitcnt vmcnt(0) lgkmcnt(0)
L_end:
    s_endpgm
.section .rodata,"a"
.p2align 6
.amdhsa_kernel recurrent_scan__sliding_block_cached__mixer_token_mlp__decode_kernel
  .amdhsa_next_free_vgpr 160
  .amdhsa_next_free_sgpr 102
  .amdhsa_accum_offset 160
  .amdhsa_group_segment_fixed_size 0
  .amdhsa_kernarg_size 104
  .amdhsa_user_sgpr_count 2
  .amdhsa_user_sgpr_kernarg_segment_ptr 1
  .amdhsa_system_sgpr_workgroup_id_x 1
.end_amdhsa_kernel
```
